```python
import torch

def _softmax(x, axis=-1):
    return torch.softmax(x, dim=axis)
def _gelu(x):
    return torch.nn.functional.gelu(x, approximate="tanh")
def _silu(x):
    return torch.nn.functional.silu(x)
def _sigmoid(x):
    return torch.sigmoid(x)
def _layernorm(x, axis=-1, eps=1e-5):
    m = x.mean(dim=axis, keepdim=True)
    v = x.var(dim=axis, keepdim=True, unbiased=False)
    return (x - m) / torch.sqrt(v + eps)
def _scatter_add(tgt, idx, src, axis=0):
    return tgt.clone().index_add_(axis, idx, src)
def _segment_sum(src, seg, n):
    out = torch.zeros((n,) + src.shape[1:], dtype=src.dtype)
    return out.index_add_(0, seg, src)
def _pad(x, pw):
    flat = tuple(v for pair in reversed(pw) for v in pair)
    return torch.nn.functional.pad(x, flat)

kernel_name = 'standalone__linear_kernel_rfa__decode'

def setup_inputs():

    _w = (lambda a: (lambda t: t.to(torch.bfloat16) if t.is_floating_point() else t)(torch.as_tensor(a)))
    B, H, Sq, Sk, D, M = 2, 32, 1, 8192, 128, 8
    return {
        "q": _w((lambda *s: torch.randn(*s, dtype=torch.bfloat16) * 0.4)(B, H, Sq, D)),
        "k": _w((lambda *s: torch.randn(*s, dtype=torch.bfloat16) * 1.6)(B, H, Sk, D)),
        "v": _w((lambda *s: torch.randn(*s, dtype=torch.bfloat16) * 1.6)(B, H, Sk, D)),
        "omega": _w((lambda *s: torch.randn(*s, dtype=torch.bfloat16) * 1.6)(M, D)),
    }

def reference(q, k, v, omega):
    d = q.shape[-1]
    m = omega.shape[0]
    scale = float(d) ** -0.25
    qs = q * scale
    ks = k * scale
    q_proj = torch.einsum("bhsd,md->bhsm", qs, omega)
    k_proj = torch.einsum("bhsd,md->bhsm", ks, omega)
    q_sq = 0.5 * torch.einsum("bhsd,bhsd->bhs", qs, qs)[..., None]
    k_sq = 0.5 * torch.einsum("bhsd,bhsd->bhs", ks, ks)[..., None]
    inv_sqrt_m = float(m) ** -0.5
    phi_q = torch.exp(q_proj - q_sq) * inv_sqrt_m + 1e-6
    phi_k = torch.exp(k_proj - k_sq) * inv_sqrt_m + 1e-6
    kv = torch.einsum("bhsm,bhsd->bhmd", phi_k, v)
    z  = torch.einsum("bhsm->bhm", phi_k)
    num = torch.einsum("bhqm,bhmd->bhqd", phi_q, kv)
    den = torch.einsum("bhqm,bhm->bhq", phi_q, z)[..., None] + 1e-6
    return num / den
```

```asm
; @launch grid=(256,1,1) block=(320,1,1) lds=90112
.amdgcn_target "amdgcn-amd-amdhsa--gfx950"
.text
.globl standalone__linear_kernel_rfa__decode_kernel
.p2align 8
.type standalone__linear_kernel_rfa__decode_kernel,@function
standalone__linear_kernel_rfa__decode_kernel:
  s_cmp_ge_u32 s2, 256
  s_cbranch_scc1 L_done
  s_memrealtime s[74:75]
  s_load_dwordx8 s[48:55], s[0:1], 0
  s_load_dwordx4 s[56:59], s[0:1], 32
  s_load_dwordx2 s[60:61], s[0:1], 48
  v_lshrrev_b32 v3, 6, v0
  v_and_b32 v0, 63, v0
  v_readfirstlane_b32 s3, v3
  v_lshlrev_b32 v200, 7, v0
  s_getpc_b64 s[62:63]
L_pc:
  v_min_u32 v200, L_codeend-L_pc-4, v200
  s_cmp_lg_u32 s3, 4
  s_cbranch_scc1 L_nocpf
  global_load_dword v201, v200, s[62:63]
L_nocpf:
  s_lshr_b32 s4, s2, 5
  s_lshl_b32 s4, s4, 3
  s_and_b32 s62, s2, 7
  s_add_u32 s4, s4, s62
  s_bfe_u32 s5, s2, 0x20003
  v_lshlrev_b32 v3, 4, v0
  s_lshl_b32 s62, s5, 2
  s_add_u32 s62, s62, s3
  s_lshl_b32 s62, s62, 12
  v_add_u32 v1, s62, v3
  s_mov_b32 s35, 65536
  s_mov_b32 s72, 131072
  s_lshl_b32 s62, s4, 21
  s_lshr_b32 s63, s4, 11
  s_mov_b32 s10, 2097152
  s_mov_b32 s11, 0x20000
  s_movk_i32 s22, 0x800
  s_mov_b32 s23, 0x20000
  s_waitcnt lgkmcnt(0)
  s_mov_b32 s20, s54
  s_mov_b32 s21, s55
  s_cmp_eq_u32 s3, 4
  s_cbranch_scc1 L_helper
  s_add_u32 s8, s50, s62
  s_addc_u32 s9, s51, s63
  s_add_u32 s12, s52, s62
  s_addc_u32 s13, s53, s63
  buffer_load_dwordx4 v[188:191], v1, s[8:11], 0 offen offset:0 nt
  buffer_load_dwordx4 v[128:131], v3, s[20:23], 0 offen offset:0
  buffer_load_dwordx4 v[132:135], v3, s[20:23], 0 offen offset:1024
  buffer_load_dwordx4 v[192:195], v1, s[8:11], 0 offen offset:1024 nt
  buffer_load_dwordx4 v[196:199], v1, s[8:11], 0 offen offset:2048 nt
  buffer_load_dwordx4 v[200:203], v1, s[8:11], 0 offen offset:3072 nt
  buffer_load_dwordx4 v[204:207], v1, s[8:11], s35 offen offset:0 nt
  s_lshl_b32 s62, s4, 15
  s_add_u32 s16, s60, s62
  s_addc_u32 s17, s61, 0
  s_load_dword s6, s[16:17], 0x1f00
  s_mov_b32 s18, 0x8000
  s_mov_b32 s19, 0x20000
  s_getreg_b32 s7, hwreg(HW_REG_XCC_ID, 0, 4)
  s_lshl_b32 s47, s5, 13
  s_mov_b32 s24, 0x3e9837f0
  s_mov_b32 s25, 0x3e9837f0
  s_mov_b32 s26, 0x3fb8aa3c
  s_mov_b32 s27, 0x3fb8aa3c
  s_mov_b32 s28, 0x3eb504f3
  s_mov_b32 s29, 0x3eb504f3
  s_mov_b32 s30, 0x358637bd
  s_mov_b32 s31, 0x358637bd
  s_mov_b32 s32, 0xffff0000
  s_mov_b32 s33, 0x05040100
  s_mov_b32 s34, 0x07060302
  s_mov_b32 s50, 0xaaaaaaaa
  s_mov_b32 s51, 0xaaaaaaaa
  s_mov_b32 s36, 0x100001
  s_mov_b32 s37, 0x10000100
  s_mov_b32 s38, 0x200002
  s_mov_b32 s39, 0x20000200
  s_mov_b32 s40, 0x400004
  s_mov_b32 s41, 0x40000400
  s_mov_b32 s42, 0x800008
  s_mov_b32 s43, 0x80000800
  v_mov_b32 v32, 0x3f80
  v_mov_b32 v33, 0x3f800000
  v_cndmask_b32 v184, 0, v32, s[36:37]
  v_cndmask_b32 v184, v184, v33, s[38:39]
  v_cndmask_b32 v185, 0, v32, s[40:41]
  v_cndmask_b32 v185, v185, v33, s[42:43]
  s_mov_b32 s44, 0x33333333
  s_mov_b32 s45, 0x33333333
  v_mov_b32 v25, 0
  v_mov_b32 v27, 0
  v_mov_b32 v32, 0xbf00
  v_mov_b32 v33, 0xbf000000
  v_cndmask_b32 v26, v33, v32, s[44:45]
  v_mov_b32 v28, 0x3f803f80
  v_mov_b32 v29, 0x3f803f80
  v_mov_b32 v30, 0x3f803f80
  v_mov_b32 v31, 0x3f803f80
  v_mov_b32 v40, 0
  v_mov_b32 v41, 0
  v_mov_b32 v42, 0
  v_mov_b32 v43, 0
  v_mov_b32 v48, 0
  v_mov_b32 v49, 0
  v_mov_b32 v50, 0
  v_mov_b32 v51, 0
  v_mov_b32 v52, 0
  v_mov_b32 v53, 0
  v_mov_b32 v54, 0
  v_mov_b32 v55, 0
  v_mov_b32 v56, 0
  v_mov_b32 v57, 0
  v_mov_b32 v58, 0
  v_mov_b32 v59, 0
  v_mov_b32 v60, 0
  v_mov_b32 v61, 0
  v_mov_b32 v62, 0
  v_mov_b32 v63, 0
  v_mov_b32 v64, 0
  v_mov_b32 v65, 0
  v_mov_b32 v66, 0
  v_mov_b32 v67, 0
  v_mov_b32 v68, 0
  v_mov_b32 v69, 0
  v_mov_b32 v70, 0
  v_mov_b32 v71, 0
  v_mov_b32 v72, 0
  v_mov_b32 v73, 0
  v_mov_b32 v74, 0
  v_mov_b32 v75, 0
  v_mov_b32 v76, 0
  v_mov_b32 v77, 0
  v_mov_b32 v78, 0
  v_mov_b32 v79, 0
  s_xor_b32 s68, s47, 0x2000
  s_xor_b32 s69, s47, 0x4000
  s_xor_b32 s70, s47, 0x6000
  s_movk_i32 s71, 0x1e00
  s_mov_b32 s73, 0
  s_lshl_b32 s62, s3, 10
  v_add_u32 v2, s62, v3
  v_lshrrev_b32 v220, 2, v2
  v_lshrrev_b32 v186, 1, v2
  v_add_u32 v186, 0x1000, v186
  v_lshrrev_b32 v221, 2, v3
  v_add_u32 v221, 16384, v221
  s_lshl_b32 s62, s3, 12
  v_add_u32 v187, s62, v3
  s_mov_b32 s20, s56
  s_mov_b32 s21, s57
  s_movk_i32 s22, 0x4000
  s_mov_b32 s23, 0x20000
  v_and_b32 v36, 0xf0, v3
  v_lshrrev_b32 v38, 9, v3
  v_lshl_add_u32 v36, v38, 1, v36
  s_lshl_b32 s62, s4, 8
  s_lshl_b32 s63, s3, 2
  s_add_u32 s62, s62, s63
  v_add_u32 v0, s62, v36
  s_lshl_b32 s62, s3, 14
  s_add_u32 s62, s62, 24576
  v_add_u32 v222, s62, v3
  s_add_u32 s66, s74, 175
  s_mov_b64 vcc, 0
  s_mov_b32 s67, 0
  s_mov_b32 s46, 15
  s_cmp_eq_u32 s46, 0
  s_waitcnt vmcnt(6)
  buffer_load_dwordx4 v[208:211], v1, s[8:11], s35 offen offset:1024 nt
  s_waitcnt vmcnt(4)
  buffer_load_dwordx4 v[212:215], v1, s[8:11], s35 offen offset:2048 nt
  v_perm_b32 v144, v192, v188, s33
  v_perm_b32 v146, v192, v188, s34
  v_perm_b32 v148, v193, v189, s33
  v_perm_b32 v150, v193, v189, s34
  v_perm_b32 v152, v194, v190, s33
  v_perm_b32 v154, v194, v190, s34
  v_perm_b32 v156, v195, v191, s33
  v_perm_b32 v158, v195, v191, s34
  v_perm_b32 v112, v132, v128, s33
  v_perm_b32 v113, v132, v128, s33
  v_perm_b32 v114, v132, v128, s34
  v_perm_b32 v115, v132, v128, s34
  v_perm_b32 v116, v133, v129, s33
  v_perm_b32 v117, v133, v129, s33
  v_perm_b32 v118, v133, v129, s34
  v_perm_b32 v119, v133, v129, s34
  v_perm_b32 v120, v134, v130, s33
  v_perm_b32 v121, v134, v130, s33
  v_perm_b32 v122, v134, v130, s34
  v_perm_b32 v123, v134, v130, s34
  v_perm_b32 v124, v135, v131, s33
  v_perm_b32 v125, v135, v131, s33
  v_perm_b32 v126, v135, v131, s34
  v_perm_b32 v127, v135, v131, s34
  s_nop 1
  v_mfma_f32_16x16x16_bf16 v[160:163], v[112:113], v[184:185], 0
  v_mfma_f32_16x16x16_bf16 v[164:167], v[114:115], v[184:185], 0
  v_mfma_f32_16x16x16_bf16 v[168:171], v[116:117], v[184:185], 0
  v_mfma_f32_16x16x16_bf16 v[172:175], v[118:119], v[184:185], 0
  s_nop 6
  v_cvt_pk_bf16_f32 v96, v160, v161
  v_cvt_pk_bf16_f32 v97, v162, v163
  v_cvt_pk_bf16_f32 v98, v164, v165
  v_cvt_pk_bf16_f32 v99, v166, v167
  v_cvt_pk_bf16_f32 v100, v168, v169
  v_cvt_pk_bf16_f32 v101, v170, v171
  v_cvt_pk_bf16_f32 v102, v172, v173
  v_cvt_pk_bf16_f32 v103, v174, v175
  s_nop 1
  v_mfma_f32_16x16x16_bf16 v[160:163], v[120:121], v[184:185], 0
  v_mfma_f32_16x16x16_bf16 v[164:167], v[122:123], v[184:185], 0
  v_mfma_f32_16x16x16_bf16 v[168:171], v[124:125], v[184:185], 0
  v_mfma_f32_16x16x16_bf16 v[172:175], v[126:127], v[184:185], 0
  s_nop 6
  v_cvt_pk_bf16_f32 v104, v160, v161
  v_cvt_pk_bf16_f32 v105, v162, v163
  v_cvt_pk_bf16_f32 v106, v164, v165
  v_cvt_pk_bf16_f32 v107, v166, v167
  v_cvt_pk_bf16_f32 v108, v168, v169
  v_cvt_pk_bf16_f32 v109, v170, v171
  v_cvt_pk_bf16_f32 v110, v172, v173
  v_cvt_pk_bf16_f32 v111, v174, v175
  s_waitcnt vmcnt(4)
  buffer_load_dwordx4 v[216:219], v1, s[8:11], s35 offen offset:3072 nt
  v_add_u32 v1, s72, v1
  s_cselect_b64 s[8:9], s[12:13], s[8:9]
  v_cndmask_b32 v80, 0, v96, s[44:45]
  v_cndmask_b32 v81, 0, v97, s[44:45]
  v_cndmask_b32 v82, 0, v98, s[44:45]
  v_cndmask_b32 v83, 0, v99, s[44:45]
  v_cndmask_b32 v84, 0, v100, s[44:45]
  v_cndmask_b32 v85, 0, v101, s[44:45]
  v_cndmask_b32 v86, 0, v102, s[44:45]
  v_cndmask_b32 v87, 0, v103, s[44:45]
  v_cndmask_b32 v88, 0, v104, s[44:45]
  v_cndmask_b32 v89, 0, v105, s[44:45]
  v_cndmask_b32 v90, 0, v106, s[44:45]
  v_cndmask_b32 v91, 0, v107, s[44:45]
  v_cndmask_b32 v92, 0, v108, s[44:45]
  v_cndmask_b32 v93, 0, v109, s[44:45]
  v_cndmask_b32 v94, 0, v110, s[44:45]
  v_cndmask_b32 v95, 0, v111, s[44:45]
  v_cndmask_b32 v96, v96, 0, s[44:45]
  v_cndmask_b32 v97, v97, 0, s[44:45]
  v_cndmask_b32 v98, v98, 0, s[44:45]
  v_cndmask_b32 v99, v99, 0, s[44:45]
  v_cndmask_b32 v100, v100, 0, s[44:45]
  v_cndmask_b32 v101, v101, 0, s[44:45]
  v_cndmask_b32 v102, v102, 0, s[44:45]
  v_cndmask_b32 v103, v103, 0, s[44:45]
  v_cndmask_b32 v104, v104, 0, s[44:45]
  v_cndmask_b32 v105, v105, 0, s[44:45]
  v_cndmask_b32 v106, v106, 0, s[44:45]
  v_cndmask_b32 v107, v107, 0, s[44:45]
  v_cndmask_b32 v108, v108, 0, s[44:45]
  v_cndmask_b32 v109, v109, 0, s[44:45]
  v_cndmask_b32 v110, v110, 0, s[44:45]
  v_cndmask_b32 v111, v111, 0, s[44:45]
  s_branch L_joinK
L_deepK0:
  s_waitcnt vmcnt(4)
  buffer_load_dwordx4 v[208:211], v1, s[8:11], s35 offen offset:1024 nt
  buffer_load_dwordx4 v[212:215], v1, s[8:11], s35 offen offset:2048 nt
  s_branch L_backK0
L_deepK1:
  s_waitcnt vmcnt(5)
  buffer_load_dwordx4 v[216:219], v1, s[8:11], s35 offen offset:3072 nt
  v_add_u32 v1, s72, v1
  s_cselect_b64 s[8:9], s[12:13], s[8:9]
  s_branch L_backK1
L_deepK2:
  s_waitcnt vmcnt(5)
  buffer_load_dwordx4 v[188:191], v1, s[8:11], 0 offen offset:0 nt
  s_branch L_backK2
L_deepK3:
  s_waitcnt vmcnt(5)
  buffer_load_dwordx4 v[192:195], v1, s[8:11], 0 offen offset:1024 nt
  s_branch L_backK3
L_deepK4:
  s_waitcnt vmcnt(5)
  buffer_load_dwordx4 v[196:199], v1, s[8:11], 0 offen offset:2048 nt
  s_branch L_backK4
L_deepK5:
  s_waitcnt vmcnt(5)
  buffer_load_dwordx4 v[200:203], v1, s[8:11], 0 offen offset:3072 nt
  s_branch L_backK5
L_deepK6:
  s_waitcnt vmcnt(5)
  buffer_load_dwordx4 v[204:207], v1, s[8:11], s35 offen offset:0 nt
  s_branch L_backK6
L_deepK7:
  s_waitcnt vmcnt(5)
  s_branch L_backK7
  .p2align 3
L_loopK:
  s_sub_u32 s46, s46, 1
  s_waitcnt lgkmcnt(0)
  s_sub_u32 s62, s74, s66
  s_add_u32 s66, s66, 107
  s_cmp_gt_i32 s62, 0
  s_cselect_b64 vcc, -1, 0
  s_cselect_b32 s62, 4, 0
  s_add_u32 s66, s66, s62
  s_cmp_eq_u32 s46, 0
  s_cselect_b32 s72, 0xffe20000, s72
  s_cbranch_vccnz L_deepK0
  s_waitcnt vmcnt(4)
  buffer_load_dwordx4 v[208:211], v1, s[8:11], s35 offen offset:1024 nt
L_backK0:
  v_mfma_f32_16x16x16_bf16 v[160:163], v[152:153], v[184:185], 0
  v_mfma_f32_16x16x16_bf16 v[164:167], v[154:155], v[184:185], 0
  v_mfma_f32_16x16x16_bf16 v[168:171], v[156:157], v[184:185], 0
  v_mfma_f32_16x16x16_bf16 v[172:175], v[158:159], v[184:185], 0
  s_nop 5
  v_pk_mul_f32 v[160:161], v[160:161], s[24:25]
  v_pk_mul_f32 v[162:163], v[162:163], s[24:25]
  v_pk_mul_f32 v[164:165], v[164:165], s[24:25]
  v_pk_mul_f32 v[166:167], v[166:167], s[24:25]
  v_cvt_pk_bf16_f32 v176, v160, v161
  v_cvt_pk_bf16_f32 v177, v162, v163
  v_cvt_pk_bf16_f32 v178, v164, v165
  v_cvt_pk_bf16_f32 v179, v166, v167
  v_pk_mul_f32 v[168:169], v[168:169], s[24:25]
  v_pk_mul_f32 v[170:171], v[170:171], s[24:25]
  v_pk_mul_f32 v[172:173], v[172:173], s[24:25]
  v_pk_mul_f32 v[174:175], v[174:175], s[24:25]
  v_mfma_f32_16x16x32_bf16 v[4:7], v[176:179], v[104:107], v[4:7]
  v_mfma_f32_16x16x32_bf16 v[12:15], v[176:179], v[176:179], v[12:15]
  v_cvt_pk_bf16_f32 v180, v168, v169
  v_cvt_pk_bf16_f32 v181, v170, v171
  v_cvt_pk_bf16_f32 v182, v172, v173
  v_cvt_pk_bf16_f32 v183, v174, v175
  s_nop 1
  v_mfma_f32_16x16x32_bf16 v[4:7], v[180:183], v[108:111], v[4:7]
  v_mfma_f32_16x16x32_bf16 v[12:15], v[180:183], v[180:183], v[12:15]
  s_cbranch_vccnz L_deepK1
  s_waitcnt vmcnt(4)
  buffer_load_dwordx4 v[212:215], v1, s[8:11], s35 offen offset:2048 nt
L_backK1:
  v_perm_b32 v144, v192, v188, s33
  v_perm_b32 v146, v192, v188, s34
  v_perm_b32 v148, v193, v189, s33
  v_perm_b32 v150, v193, v189, s34
  v_perm_b32 v152, v194, v190, s33
  v_perm_b32 v154, v194, v190, s34
  v_perm_b32 v156, v195, v191, s33
  v_perm_b32 v158, v195, v191, s34
  v_cvt_pk_bf16_f32 v8, v8, v12
  v_cvt_pk_bf16_f32 v9, v9, v13
  v_cvt_pk_bf16_f32 v10, v10, v14
  v_cvt_pk_bf16_f32 v11, v11, v15
  v_cvt_pk_bf16_f32 v32, v4, v5
  v_cvt_pk_bf16_f32 v33, v6, v7
  v_cndmask_b32 v24, 0, v8, s[36:37]
  v_cndmask_b32 v24, v24, v9, s[38:39]
  v_cndmask_b32 v24, v24, v10, s[40:41]
  v_cndmask_b32 v24, v24, v11, s[42:43]
  v_lshlrev_b32 v16, 16, v32
  v_and_b32 v17, s32, v32
  v_lshlrev_b32 v18, 16, v33
  v_and_b32 v19, s32, v33
  s_nop 1
  v_mfma_f32_16x16x16_bf16 v[16:19], v[24:25], v[26:27], v[16:19]
  s_cbranch_vccnz L_deepK2
  s_waitcnt vmcnt(4)
  buffer_load_dwordx4 v[216:219], v1, s[8:11], s35 offen offset:3072 nt
  v_add_u32 v1, s72, v1
  s_cselect_b64 s[8:9], s[12:13], s[8:9]
L_backK2:
  s_nop 5
  v_cvt_pk_bf16_f32 v32, v16, v17
  v_cvt_pk_bf16_f32 v33, v18, v19
  v_lshlrev_b32 v16, 16, v32
  v_and_b32 v17, s32, v32
  v_lshlrev_b32 v18, 16, v33
  v_and_b32 v19, s32, v33
  v_pk_mul_f32 v[16:17], v[16:17], s[26:27]
  v_pk_mul_f32 v[18:19], v[18:19], s[26:27]
  v_exp_f32 v16, v16
  v_exp_f32 v17, v17
  v_exp_f32 v18, v18
  v_exp_f32 v19, v19
  s_nop 0
  v_cvt_pk_bf16_f32 v32, v16, v17
  v_cvt_pk_bf16_f32 v33, v18, v19
  v_lshlrev_b32 v16, 16, v32
  v_and_b32 v17, s32, v32
  v_lshlrev_b32 v18, 16, v33
  v_and_b32 v19, s32, v33
  v_pk_mul_f32 v[16:17], v[16:17], s[28:29]
  v_pk_mul_f32 v[18:19], v[18:19], s[28:29]
  v_cvt_pk_bf16_f32 v32, v16, v17
  v_cvt_pk_bf16_f32 v33, v18, v19
  v_lshlrev_b32 v16, 16, v32
  v_and_b32 v17, s32, v32
  v_lshlrev_b32 v18, 16, v33
  v_and_b32 v19, s32, v33
  v_pk_add_f32 v[16:17], v[16:17], s[30:31]
  v_pk_add_f32 v[18:19], v[18:19], s[30:31]
  v_cvt_pk_bf16_f32 v32, v16, v17
  v_cvt_pk_bf16_f32 v33, v18, v19
  v_cndmask_b32 v20, 0, v32, s[44:45]
  v_cndmask_b32 v21, 0, v33, s[44:45]
  v_cndmask_b32 v22, v32, 0, s[44:45]
  v_cndmask_b32 v23, v33, 0, s[44:45]
  ds_write_b128 v222, v[20:23]
  v_add_u32 v222, 0x400, v222
  v_mfma_f32_16x16x32_bf16 v[40:43], v[20:23], v[28:31], v[40:43]
L_joinK:
  s_cbranch_vccnz L_deepK3
  s_waitcnt vmcnt(4)
  buffer_load_dwordx4 v[188:191], v1, s[8:11], 0 offen offset:0 nt
L_backK3:
  v_perm_b32 v145, v200, v196, s33
  v_perm_b32 v147, v200, v196, s34
  v_perm_b32 v149, v201, v197, s33
  v_perm_b32 v151, v201, v197, s34
  v_perm_b32 v153, v202, v198, s33
  v_perm_b32 v155, v202, v198, s34
  v_perm_b32 v157, v203, v199, s33
  v_perm_b32 v159, v203, v199, s34
  s_nop 1
  v_mfma_f32_16x16x16_bf16 v[160:163], v[144:145], v[184:185], 0
  v_mfma_f32_16x16x16_bf16 v[164:167], v[146:147], v[184:185], 0
  v_mfma_f32_16x16x16_bf16 v[168:171], v[148:149], v[184:185], 0
  v_mfma_f32_16x16x16_bf16 v[172:175], v[150:151], v[184:185], 0
  s_nop 5
  v_pk_mul_f32 v[160:161], v[160:161], s[24:25]
  v_pk_mul_f32 v[162:163], v[162:163], s[24:25]
  v_pk_mul_f32 v[164:165], v[164:165], s[24:25]
  v_pk_mul_f32 v[166:167], v[166:167], s[24:25]
  v_cvt_pk_bf16_f32 v176, v160, v161
  v_cvt_pk_bf16_f32 v177, v162, v163
  v_cvt_pk_bf16_f32 v178, v164, v165
  v_cvt_pk_bf16_f32 v179, v166, v167
  v_pk_mul_f32 v[168:169], v[168:169], s[24:25]
  v_pk_mul_f32 v[170:171], v[170:171], s[24:25]
  v_pk_mul_f32 v[172:173], v[172:173], s[24:25]
  v_pk_mul_f32 v[174:175], v[174:175], s[24:25]
  v_mfma_f32_16x16x32_bf16 v[4:7], v[176:179], v[80:83], 0
  v_mfma_f32_16x16x32_bf16 v[8:11], v[176:179], v[176:179], 0
  v_cvt_pk_bf16_f32 v180, v168, v169
  v_cvt_pk_bf16_f32 v181, v170, v171
  v_cvt_pk_bf16_f32 v182, v172, v173
  v_cvt_pk_bf16_f32 v183, v174, v175
  s_nop 1
  v_mfma_f32_16x16x32_bf16 v[4:7], v[180:183], v[84:87], v[4:7]
  v_mfma_f32_16x16x32_bf16 v[8:11], v[180:183], v[180:183], v[8:11]
  s_cbranch_vccnz L_deepK4
  s_waitcnt vmcnt(4)
  buffer_load_dwordx4 v[192:195], v1, s[8:11], 0 offen offset:1024 nt
L_backK4:
  s_memrealtime s[74:75]
  v_mfma_f32_16x16x16_bf16 v[160:163], v[152:153], v[184:185], 0
  v_mfma_f32_16x16x16_bf16 v[164:167], v[154:155], v[184:185], 0
  v_mfma_f32_16x16x16_bf16 v[168:171], v[156:157], v[184:185], 0
  v_mfma_f32_16x16x16_bf16 v[172:175], v[158:159], v[184:185], 0
  s_nop 5
  v_pk_mul_f32 v[160:161], v[160:161], s[24:25]
  v_pk_mul_f32 v[162:163], v[162:163], s[24:25]
  v_pk_mul_f32 v[164:165], v[164:165], s[24:25]
  v_pk_mul_f32 v[166:167], v[166:167], s[24:25]
  v_cvt_pk_bf16_f32 v176, v160, v161
  v_cvt_pk_bf16_f32 v177, v162, v163
  v_cvt_pk_bf16_f32 v178, v164, v165
  v_cvt_pk_bf16_f32 v179, v166, v167
  v_pk_mul_f32 v[168:169], v[168:169], s[24:25]
  v_pk_mul_f32 v[170:171], v[170:171], s[24:25]
  v_pk_mul_f32 v[172:173], v[172:173], s[24:25]
  v_pk_mul_f32 v[174:175], v[174:175], s[24:25]
  v_mfma_f32_16x16x32_bf16 v[4:7], v[176:179], v[88:91], v[4:7]
  v_mfma_f32_16x16x32_bf16 v[8:11], v[176:179], v[176:179], v[8:11]
  v_cvt_pk_bf16_f32 v180, v168, v169
  v_cvt_pk_bf16_f32 v181, v170, v171
  v_cvt_pk_bf16_f32 v182, v172, v173
  v_cvt_pk_bf16_f32 v183, v174, v175
  s_nop 1
  v_mfma_f32_16x16x32_bf16 v[4:7], v[180:183], v[92:95], v[4:7]
  v_mfma_f32_16x16x32_bf16 v[8:11], v[180:183], v[180:183], v[8:11]
  s_cbranch_vccnz L_deepK5
  s_waitcnt vmcnt(4)
  buffer_load_dwordx4 v[196:199], v1, s[8:11], 0 offen offset:2048 nt
L_backK5:
  v_perm_b32 v144, v208, v204, s33
  v_perm_b32 v146, v208, v204, s34
  v_perm_b32 v148, v209, v205, s33
  v_perm_b32 v150, v209, v205, s34
  v_perm_b32 v152, v210, v206, s33
  v_perm_b32 v154, v210, v206, s34
  v_perm_b32 v156, v211, v207, s33
  v_perm_b32 v158, v211, v207, s34
  s_cbranch_vccnz L_deepK6
  s_waitcnt vmcnt(4)
  buffer_load_dwordx4 v[200:203], v1, s[8:11], 0 offen offset:3072 nt
L_backK6:
  s_cbranch_vccnz L_deepK7
  s_waitcnt vmcnt(4)
  buffer_load_dwordx4 v[204:207], v1, s[8:11], s35 offen offset:0 nt
L_backK7:
  v_perm_b32 v145, v216, v212, s33
  v_perm_b32 v147, v216, v212, s34
  v_perm_b32 v149, v217, v213, s33
  v_perm_b32 v151, v217, v213, s34
  v_perm_b32 v153, v218, v214, s33
  v_perm_b32 v155, v218, v214, s34
  v_perm_b32 v157, v219, v215, s33
  v_perm_b32 v159, v219, v215, s34
  s_nop 1
  v_mfma_f32_16x16x16_bf16 v[160:163], v[144:145], v[184:185], 0
  v_mfma_f32_16x16x16_bf16 v[164:167], v[146:147], v[184:185], 0
  v_mfma_f32_16x16x16_bf16 v[168:171], v[148:149], v[184:185], 0
  v_mfma_f32_16x16x16_bf16 v[172:175], v[150:151], v[184:185], 0
  s_nop 5
  v_pk_mul_f32 v[160:161], v[160:161], s[24:25]
  v_pk_mul_f32 v[162:163], v[162:163], s[24:25]
  v_pk_mul_f32 v[164:165], v[164:165], s[24:25]
  v_pk_mul_f32 v[166:167], v[166:167], s[24:25]
  v_cvt_pk_bf16_f32 v176, v160, v161
  v_cvt_pk_bf16_f32 v177, v162, v163
  v_cvt_pk_bf16_f32 v178, v164, v165
  v_cvt_pk_bf16_f32 v179, v166, v167
  v_pk_mul_f32 v[168:169], v[168:169], s[24:25]
  v_pk_mul_f32 v[170:171], v[170:171], s[24:25]
  v_pk_mul_f32 v[172:173], v[172:173], s[24:25]
  v_pk_mul_f32 v[174:175], v[174:175], s[24:25]
  v_mfma_f32_16x16x32_bf16 v[4:7], v[176:179], v[96:99], v[4:7]
  v_mfma_f32_16x16x32_bf16 v[12:15], v[176:179], v[176:179], 0
  v_cvt_pk_bf16_f32 v180, v168, v169
  v_cvt_pk_bf16_f32 v181, v170, v171
  v_cvt_pk_bf16_f32 v182, v172, v173
  v_cvt_pk_bf16_f32 v183, v174, v175
  s_nop 1
  v_mfma_f32_16x16x32_bf16 v[4:7], v[180:183], v[100:103], v[4:7]
  v_mfma_f32_16x16x32_bf16 v[12:15], v[180:183], v[180:183], v[12:15]
  s_cbranch_scc0 L_loopK
  s_mov_b32 s72, 131072
  s_add_u32 s66, s66, 107
  s_mov_b64 vcc, 0
  s_waitcnt vmcnt(4)
  buffer_load_dwordx4 v[208:211], v1, s[8:11], s35 offen offset:1024 nt
  v_mfma_f32_16x16x16_bf16 v[160:163], v[152:153], v[184:185], 0
  v_mfma_f32_16x16x16_bf16 v[164:167], v[154:155], v[184:185], 0
  v_mfma_f32_16x16x16_bf16 v[168:171], v[156:157], v[184:185], 0
  v_mfma_f32_16x16x16_bf16 v[172:175], v[158:159], v[184:185], 0
  s_nop 5
  v_pk_mul_f32 v[160:161], v[160:161], s[24:25]
  v_pk_mul_f32 v[162:163], v[162:163], s[24:25]
  v_pk_mul_f32 v[164:165], v[164:165], s[24:25]
  v_pk_mul_f32 v[166:167], v[166:167], s[24:25]
  v_cvt_pk_bf16_f32 v176, v160, v161
  v_cvt_pk_bf16_f32 v177, v162, v163
  v_cvt_pk_bf16_f32 v178, v164, v165
  v_cvt_pk_bf16_f32 v179, v166, v167
  v_pk_mul_f32 v[168:169], v[168:169], s[24:25]
  v_pk_mul_f32 v[170:171], v[170:171], s[24:25]
  v_pk_mul_f32 v[172:173], v[172:173], s[24:25]
  v_pk_mul_f32 v[174:175], v[174:175], s[24:25]
  v_mfma_f32_16x16x32_bf16 v[4:7], v[176:179], v[104:107], v[4:7]
  v_mfma_f32_16x16x32_bf16 v[12:15], v[176:179], v[176:179], v[12:15]
  v_cvt_pk_bf16_f32 v180, v168, v169
  v_cvt_pk_bf16_f32 v181, v170, v171
  v_cvt_pk_bf16_f32 v182, v172, v173
  v_cvt_pk_bf16_f32 v183, v174, v175
  s_nop 1
  v_mfma_f32_16x16x32_bf16 v[4:7], v[180:183], v[108:111], v[4:7]
  v_mfma_f32_16x16x32_bf16 v[12:15], v[180:183], v[180:183], v[12:15]
  s_waitcnt vmcnt(4)
  buffer_load_dwordx4 v[212:215], v1, s[8:11], s35 offen offset:2048 nt
  v_perm_b32 v112, v192, v188, s33
  v_perm_b32 v116, v192, v188, s34
  v_perm_b32 v120, v193, v189, s33
  v_perm_b32 v124, v193, v189, s34
  v_perm_b32 v128, v194, v190, s33
  v_perm_b32 v132, v194, v190, s34
  v_perm_b32 v136, v195, v191, s33
  v_perm_b32 v140, v195, v191, s34
  v_cvt_pk_bf16_f32 v8, v8, v12
  v_cvt_pk_bf16_f32 v9, v9, v13
  v_cvt_pk_bf16_f32 v10, v10, v14
  v_cvt_pk_bf16_f32 v11, v11, v15
  v_cvt_pk_bf16_f32 v32, v4, v5
  v_cvt_pk_bf16_f32 v33, v6, v7
  v_cndmask_b32 v24, 0, v8, s[36:37]
  v_cndmask_b32 v24, v24, v9, s[38:39]
  v_cndmask_b32 v24, v24, v10, s[40:41]
  v_cndmask_b32 v24, v24, v11, s[42:43]
  v_lshlrev_b32 v16, 16, v32
  v_and_b32 v17, s32, v32
  v_lshlrev_b32 v18, 16, v33
  v_and_b32 v19, s32, v33
  s_nop 1
  v_mfma_f32_16x16x16_bf16 v[16:19], v[24:25], v[26:27], v[16:19]
  s_waitcnt vmcnt(4)
  buffer_load_dwordx4 v[216:219], v1, s[8:11], s35 offen offset:3072 nt
  v_add_u32 v1, s72, v1
  s_nop 0
  s_nop 5
  v_cvt_pk_bf16_f32 v32, v16, v17
  v_cvt_pk_bf16_f32 v33, v18, v19
  v_lshlrev_b32 v16, 16, v32
  v_and_b32 v17, s32, v32
  v_lshlrev_b32 v18, 16, v33
  v_and_b32 v19, s32, v33
  v_pk_mul_f32 v[16:17], v[16:17], s[26:27]
  v_pk_mul_f32 v[18:19], v[18:19], s[26:27]
  v_exp_f32 v16, v16
  v_exp_f32 v17, v17
  v_exp_f32 v18, v18
  v_exp_f32 v19, v19
  s_nop 0
  v_cvt_pk_bf16_f32 v32, v16, v17
  v_cvt_pk_bf16_f32 v33, v18, v19
  v_lshlrev_b32 v16, 16, v32
  v_and_b32 v17, s32, v32
  v_lshlrev_b32 v18, 16, v33
  v_and_b32 v19, s32, v33
  v_pk_mul_f32 v[16:17], v[16:17], s[28:29]
  v_pk_mul_f32 v[18:19], v[18:19], s[28:29]
  v_cvt_pk_bf16_f32 v32, v16, v17
  v_cvt_pk_bf16_f32 v33, v18, v19
  v_lshlrev_b32 v16, 16, v32
  v_and_b32 v17, s32, v32
  v_lshlrev_b32 v18, 16, v33
  v_and_b32 v19, s32, v33
  v_pk_add_f32 v[16:17], v[16:17], s[30:31]
  v_pk_add_f32 v[18:19], v[18:19], s[30:31]
  v_cvt_pk_bf16_f32 v32, v16, v17
  v_cvt_pk_bf16_f32 v33, v18, v19
  v_cndmask_b32 v20, 0, v32, s[44:45]
  v_cndmask_b32 v21, 0, v33, s[44:45]
  v_cndmask_b32 v22, v32, 0, s[44:45]
  v_cndmask_b32 v23, v33, 0, s[44:45]
  ds_write_b128 v222, v[20:23]
  v_add_u32 v222, 0x400, v222
  v_mfma_f32_16x16x32_bf16 v[40:43], v[20:23], v[28:31], v[40:43]
  v_add_u32 v222, 0xffffc000, v222
  s_mov_b32 s46, 15
  s_cmp_eq_u32 s46, 0
  s_branch L_joinV
L_deepV0:
  s_waitcnt vmcnt(4)
  buffer_load_dwordx4 v[208:211], v1, s[8:11], s35 offen offset:1024 nt
  buffer_load_dwordx4 v[212:215], v1, s[8:11], s35 offen offset:2048 nt
  s_branch L_backV0
L_last0:
  s_waitcnt vmcnt(4)
  buffer_load_dwordx4 v[208:211], v1, s[8:11], s35 offen offset:1024 nt
  buffer_load_dwordx4 v[212:215], v1, s[8:11], s35 offen offset:2048 nt
  s_branch L_backV0
L_deepV1:
  s_waitcnt vmcnt(5)
  buffer_load_dwordx4 v[216:219], v1, s[8:11], s35 offen offset:3072 nt
  v_add_u32 v1, s72, v1
  s_branch L_backV1
L_last1:
  s_waitcnt vmcnt(5)
  buffer_load_dwordx4 v[216:219], v1, s[8:11], s35 offen offset:3072 nt
  v_add_u32 v1, s72, v1
  buffer_load_dwordx4 v[36:39], off, s[16:19], s71 sc1
  s_branch L_backV1
L_deepV2:
  s_waitcnt vmcnt(5)
  buffer_load_dwordx4 v[188:191], v1, s[8:11], 0 offen offset:0 nt
  s_branch L_backV2
L_last2:
  s_waitcnt vmcnt(6)
  s_branch L_backV2
L_deepV3:
  s_waitcnt vmcnt(5)
  buffer_load_dwordx4 v[192:195], v1, s[8:11], 0 offen offset:1024 nt
  s_branch L_backV3
L_last3:
  s_waitcnt vmcnt(5)
  s_branch L_backV3
L_deepV4:
  s_waitcnt vmcnt(5)
  buffer_load_dwordx4 v[196:199], v1, s[8:11], 0 offen offset:2048 nt
  s_branch L_backV4
L_last4:
  s_waitcnt vmcnt(4)
  buffer_load_dwordx4 v[160:163], v2, s[16:19], s68 offen sc1
  buffer_load_dwordx2 v[164:165], v186, s[16:19], s68 offen sc1
  buffer_load_dwordx4 v[168:171], v2, s[16:19], s69 offen sc1
  buffer_load_dwordx2 v[172:173], v186, s[16:19], s69 offen sc1
  buffer_load_dwordx4 v[176:179], v2, s[16:19], s70 offen sc1
  buffer_load_dwordx2 v[180:181], v186, s[16:19], s70 offen sc1
  s_branch L_backV4
L_deepV5:
  s_waitcnt vmcnt(5)
  buffer_load_dwordx4 v[200:203], v1, s[8:11], 0 offen offset:3072 nt
  s_branch L_backV5
L_last5:
  s_waitcnt vmcnt(9)
  s_branch L_backV5
L_deepV6:
  s_waitcnt vmcnt(5)
  buffer_load_dwordx4 v[204:207], v1, s[8:11], s35 offen offset:0 nt
  s_branch L_backV6
L_last6:
  s_waitcnt vmcnt(8)
  s_branch L_backV6
L_deepV7:
  s_waitcnt vmcnt(5)
  s_branch L_backV7
L_last7:
  s_waitcnt vmcnt(7)
  s_branch L_backV7
  .p2align 3
L_loopV:
  s_sub_u32 s46, s46, 1
  s_waitcnt lgkmcnt(0)
  s_sub_u32 s62, s74, s66
  s_add_u32 s66, s66, 106
  s_cmp_gt_i32 s62, 0
  s_cselect_b64 vcc, -1, 0
  s_cselect_b32 s62, 4, 0
  s_add_u32 s66, s66, s62
  s_cmp_eq_u32 s46, 0
  s_cbranch_scc1 L_last0
  s_cbranch_vccnz L_deepV0
  s_waitcnt vmcnt(4)
  buffer_load_dwordx4 v[208:211], v1, s[8:11], s35 offen offset:1024 nt
L_backV0:
  s_cbranch_scc1 L_last1
  s_cbranch_vccnz L_deepV1
  s_waitcnt vmcnt(4)
  buffer_load_dwordx4 v[212:215], v1, s[8:11], s35 offen offset:2048 nt
L_backV1:
  v_perm_b32 v112, v192, v188, s33
  v_perm_b32 v116, v192, v188, s34
  v_perm_b32 v120, v193, v189, s33
  v_perm_b32 v124, v193, v189, s34
  v_perm_b32 v128, v194, v190, s33
  v_perm_b32 v132, v194, v190, s34
  v_perm_b32 v136, v195, v191, s33
  v_perm_b32 v140, v195, v191, s34
  s_cbranch_scc1 L_last2
  s_cbranch_vccnz L_deepV2
  s_waitcnt vmcnt(4)
  buffer_load_dwordx4 v[216:219], v1, s[8:11], s35 offen offset:3072 nt
  v_add_u32 v1, s72, v1
L_backV2:
L_joinV:
  s_cbranch_scc1 L_last3
  s_cbranch_vccnz L_deepV3
  s_waitcnt vmcnt(4)
  buffer_load_dwordx4 v[188:191], v1, s[8:11], 0 offen offset:0 nt
L_backV3:
  v_perm_b32 v113, v200, v196, s33
  v_perm_b32 v117, v200, v196, s34
  v_perm_b32 v121, v201, v197, s33
  v_perm_b32 v125, v201, v197, s34
  v_perm_b32 v129, v202, v198, s33
  v_perm_b32 v133, v202, v198, s34
  v_perm_b32 v137, v203, v199, s33
  v_perm_b32 v141, v203, v199, s34
  s_cbranch_scc1 L_last4
  s_cbranch_vccnz L_deepV4
  s_waitcnt vmcnt(4)
  buffer_load_dwordx4 v[192:195], v1, s[8:11], 0 offen offset:1024 nt
L_backV4:
  s_memrealtime s[74:75]
  ds_read_b128 v[20:23], v222
  v_add_u32 v222, 0x400, v222
  s_cbranch_scc1 L_last5
  s_cbranch_vccnz L_deepV5
  s_waitcnt vmcnt(4)
  buffer_load_dwordx4 v[196:199], v1, s[8:11], 0 offen offset:2048 nt
L_backV5:
  v_perm_b32 v114, v208, v204, s33
  v_perm_b32 v118, v208, v204, s34
  v_perm_b32 v122, v209, v205, s33
  v_perm_b32 v126, v209, v205, s34
  v_perm_b32 v130, v210, v206, s33
  v_perm_b32 v134, v210, v206, s34
  v_perm_b32 v138, v211, v207, s33
  v_perm_b32 v142, v211, v207, s34
  s_cbranch_scc1 L_last6
  s_cbranch_vccnz L_deepV6
  s_waitcnt vmcnt(4)
  buffer_load_dwordx4 v[200:203], v1, s[8:11], 0 offen offset:3072 nt
L_backV6:
  s_cbranch_scc1 L_last7
  s_cbranch_vccnz L_deepV7
  s_waitcnt vmcnt(4)
  buffer_load_dwordx4 v[204:207], v1, s[8:11], s35 offen offset:0 nt
L_backV7:
  v_perm_b32 v115, v216, v212, s33
  v_perm_b32 v119, v216, v212, s34
  v_perm_b32 v123, v217, v213, s33
  v_perm_b32 v127, v217, v213, s34
  v_perm_b32 v131, v218, v214, s33
  v_perm_b32 v135, v218, v214, s34
  v_perm_b32 v139, v219, v215, s33
  v_perm_b32 v143, v219, v215, s34
  s_waitcnt lgkmcnt(0)
  v_mfma_f32_16x16x32_bf16 v[48:51], v[20:23], v[112:115], v[48:51]
  v_mfma_f32_16x16x32_bf16 v[52:55], v[20:23], v[116:119], v[52:55]
  v_mfma_f32_16x16x32_bf16 v[56:59], v[20:23], v[120:123], v[56:59]
  v_mfma_f32_16x16x32_bf16 v[60:63], v[20:23], v[124:127], v[60:63]
  v_mfma_f32_16x16x32_bf16 v[64:67], v[20:23], v[128:131], v[64:67]
  v_mfma_f32_16x16x32_bf16 v[68:71], v[20:23], v[132:135], v[68:71]
  v_mfma_f32_16x16x32_bf16 v[72:75], v[20:23], v[136:139], v[72:75]
  v_mfma_f32_16x16x32_bf16 v[76:79], v[20:23], v[140:143], v[76:79]
  s_cbranch_scc0 L_loopV
  v_pk_add_f32 v[40:41], v[40:41], v[42:43]
  v_cndmask_b32 v32, v40, v41, s[50:51]
  ds_write_b32 v220, v32 offset:16384
  v_pk_add_f32 v[48:49], v[48:49], v[50:51]
  v_pk_add_f32 v[50:51], v[52:53], v[54:55]
  ds_write_b128 v187, v[48:51] offset:0
  v_pk_add_f32 v[56:57], v[56:57], v[58:59]
  v_pk_add_f32 v[58:59], v[60:61], v[62:63]
  ds_write_b128 v187, v[56:59] offset:1024
  v_pk_add_f32 v[64:65], v[64:65], v[66:67]
  v_pk_add_f32 v[66:67], v[68:69], v[70:71]
  ds_write_b128 v187, v[64:67] offset:2048
  v_pk_add_f32 v[72:73], v[72:73], v[74:75]
  v_pk_add_f32 v[74:75], v[76:77], v[78:79]
  ds_write_b128 v187, v[72:75] offset:3072
  s_waitcnt lgkmcnt(0)
  s_add_u32 s6, s6, 0x9e3779b9
  s_add_u32 s71, s6, s7
  s_barrier
  ds_read_b128 v[80:83], v2 offset:0
  ds_read_b128 v[84:87], v2 offset:4096
  ds_read_b128 v[88:91], v2 offset:8192
  ds_read_b128 v[92:95], v2 offset:12288
  ds_read2_b32 v[32:33], v221 offset0:0 offset1:64
  ds_read2_b32 v[34:35], v221 offset0:128 offset1:192
  ds_read_b128 v[44:47], v3 offset:20480
  s_waitcnt vmcnt(6)
  v_bitop3_b32 v36, v36, v37, s71 bitop3:0x7e
  v_bitop3_b32 v38, v38, v39, s71 bitop3:0x7e
  v_or_b32 v36, v36, v38
  v_cmp_ne_u32 vcc, 0, v36
  s_waitcnt lgkmcnt(1)
  v_pk_add_f32 v[80:81], v[80:81], v[84:85]
  v_pk_add_f32 v[82:83], v[82:83], v[86:87]
  v_pk_add_f32 v[88:89], v[88:89], v[92:93]
  v_pk_add_f32 v[90:91], v[90:91], v[94:95]
  v_pk_add_f32 v[32:33], v[32:33], v[34:35]
  v_pk_add_f32 v[80:81], v[80:81], v[88:89]
  v_pk_add_f32 v[82:83], v[82:83], v[90:91]
  v_add_f32 v97, v32, v33
  s_cbranch_vccnz L_far
  buffer_store_dwordx4 v[80:83], v2, s[16:19], s47 offen
  v_bitop3_b32 v96, v80, v81, s6 bitop3:0x96
  v_bitop3_b32 v32, v82, v83, v97 bitop3:0x96
  v_xor_b32 v96, v96, v32
  buffer_store_dwordx2 v[96:97], v186, s[16:19], s47 offen
L_pub:
  s_waitcnt vmcnt(2)
  v_bitop3_b32 v32, v160, v161, s6 bitop3:0x96
  v_bitop3_b32 v33, v168, v169, s6 bitop3:0x96
  v_bitop3_b32 v34, v176, v177, s6 bitop3:0x96
  v_bitop3_b32 v32, v162, v163, v32 bitop3:0x96
  v_bitop3_b32 v33, v170, v171, v33 bitop3:0x96
  v_bitop3_b32 v34, v178, v179, v34 bitop3:0x96
  v_bitop3_b32 v32, v164, v165, v32 bitop3:0x96
  v_bitop3_b32 v33, v172, v173, v33 bitop3:0x96
  v_bitop3_b32 v34, v180, v181, v34 bitop3:0x96
  v_or3_b32 v32, v32, v33, v34
  v_cmp_ne_u32 vcc, 0, v32
  s_nop 1
  s_cbranch_vccnz L_try2
L_use1:
  v_pk_add_f32 v[80:81], v[80:81], v[160:161]
  v_pk_add_f32 v[82:83], v[82:83], v[162:163]
  v_pk_add_f32 v[168:169], v[168:169], v[176:177]
  v_pk_add_f32 v[170:171], v[170:171], v[178:179]
  v_add_f32 v97, v97, v165
  v_add_f32 v173, v173, v181
  v_pk_add_f32 v[80:81], v[80:81], v[168:169]
  v_pk_add_f32 v[82:83], v[82:83], v[170:171]
  v_add_f32 v97, v97, v173
L_final:
  s_waitcnt lgkmcnt(0)
  v_cvt_pk_bf16_f32 v32, v80, v81
  v_cvt_pk_bf16_f32 v33, v82, v83
  v_cvt_pk_bf16_f32 v34, v97, v97
  v_lshlrev_b32 v80, 16, v32
  v_and_b32 v81, s32, v32
  v_lshlrev_b32 v82, 16, v33
  v_and_b32 v83, s32, v33
  v_and_b32 v97, s32, v34
  v_mul_f32 v97, v97, v46
  v_mul_f32 v80, v80, v44
  v_mul_f32 v82, v82, v44
  v_add_f32_dpp v97, v97, v97 quad_perm:[1,0,3,2] row_mask:0xf bank_mask:0xf
  v_fmac_f32 v80, v81, v45
  v_fmac_f32 v82, v83, v45
  v_mov_b32 v98, v97
  s_nop 1
  v_permlane32_swap_b32 v80, v82
  v_permlane32_swap_b32 v97, v98
  v_add_f32 v80, v80, v82
  v_add_f32 v97, v97, v98
  s_nop 1
  v_permlane16_swap_b32 v80, v97
  v_add_f32 v80, v80, v97
  v_cvt_pk_bf16_f32 v32, v80, v80
  v_and_b32 v80, s32, v32
  v_add_f32 v81, s30, v80
  v_cvt_pk_bf16_f32 v32, v81, v81
  v_and_b32 v81, s32, v32
  v_mul_f32 v81, 0x3e800000, v81
  v_rcp_f32 v81, v81
  v_mul_f32 v80, 0x3e800000, v80
  v_mov_b32 v33, s6
  s_nop 0
  v_permlane16_swap_b32 v81, v82
  v_mul_f32 v80, v80, v82
  v_cvt_pk_bf16_f32 v80, v80, v80
  s_mov_b32 exec_lo, 0xffff
  s_mov_b32 exec_hi, 0xffff
  buffer_store_short v80, v0, s[20:23], 0 offen
  s_cmp_lg_u32 s3, 0
  s_cbranch_scc1 L_done
  s_mov_b64 exec, 1
  s_movk_i32 s64, 0x1f00
  buffer_store_dword v33, off, s[16:19], s64
  s_endpgm
L_try2:
  s_waitcnt vmcnt(0)
  buffer_load_dwordx4 v[160:163], v2, s[16:19], s68 offen sc1
  buffer_load_dwordx2 v[164:165], v186, s[16:19], s68 offen sc1
  buffer_load_dwordx4 v[168:171], v2, s[16:19], s69 offen sc1
  buffer_load_dwordx2 v[172:173], v186, s[16:19], s69 offen sc1
  buffer_load_dwordx4 v[176:179], v2, s[16:19], s70 offen sc1
  buffer_load_dwordx2 v[180:181], v186, s[16:19], s70 offen sc1
L_try3:
  s_waitcnt vmcnt(0)
  v_bitop3_b32 v32, v160, v161, s6 bitop3:0x96
  v_bitop3_b32 v33, v168, v169, s6 bitop3:0x96
  v_bitop3_b32 v34, v176, v177, s6 bitop3:0x96
  v_bitop3_b32 v32, v162, v163, v32 bitop3:0x96
  v_bitop3_b32 v33, v170, v171, v33 bitop3:0x96
  v_bitop3_b32 v34, v178, v179, v34 bitop3:0x96
  v_bitop3_b32 v32, v164, v165, v32 bitop3:0x96
  v_bitop3_b32 v33, v172, v173, v33 bitop3:0x96
  v_bitop3_b32 v34, v180, v181, v34 bitop3:0x96
  v_or3_b32 v32, v32, v33, v34
  v_cmp_ne_u32 vcc, 0, v32
  s_nop 1
  s_cbranch_vccz L_use1
  s_sub_u32 s73, s73, 1
  s_cbranch_scc1 L_done
  buffer_load_dwordx4 v[160:163], v2, s[16:19], s68 offen sc1
  buffer_load_dwordx2 v[164:165], v186, s[16:19], s68 offen sc1
  buffer_load_dwordx4 v[168:171], v2, s[16:19], s69 offen sc1
  buffer_load_dwordx2 v[172:173], v186, s[16:19], s69 offen sc1
  buffer_load_dwordx4 v[176:179], v2, s[16:19], s70 offen sc1
  buffer_load_dwordx2 v[180:181], v186, s[16:19], s70 offen sc1
  s_branch L_try3
L_far:
  buffer_store_dwordx4 v[80:83], v2, s[16:19], s47 offen sc1
  v_bitop3_b32 v96, v80, v81, s6 bitop3:0x96
  v_bitop3_b32 v32, v82, v83, v97 bitop3:0x96
  v_xor_b32 v96, v96, v32
  buffer_store_dwordx2 v[96:97], v186, s[16:19], s47 offen sc1
  s_cmp_eq_u32 s5, 0
  s_cselect_b32 s73, 0x40000, 0
  s_branch L_pub
L_fin:
L_done:
  s_endpgm
L_helper:
  buffer_load_dwordx4 v[128:131], v3, s[20:23], 0 offen offset:0
  buffer_load_dwordx4 v[132:135], v3, s[20:23], 0 offen offset:1024
  s_mov_b32 s8, s48
  s_mov_b32 s9, s49
  s_movk_i32 s10, 0x4000
  s_mov_b32 s11, 0x20000
  s_lshl_b32 s62, s4, 8
  v_and_b32 v35, 48, v0
  v_lshl_add_u32 v35, v35, 2, s62
  buffer_load_dwordx4 v[144:147], v35, s[8:11], 0 offen offset:0
  buffer_load_dwordx4 v[148:151], v35, s[8:11], 0 offen offset:16
  buffer_load_dwordx4 v[152:155], v35, s[8:11], 0 offen offset:32
  buffer_load_dwordx4 v[156:159], v35, s[8:11], 0 offen offset:48
  s_lshl_b32 s62, s4, 15
  s_add_u32 s16, s60, s62
  s_addc_u32 s17, s61, 0
  s_load_dword s6, s[16:17], 0x1f00
  s_mov_b32 s18, 0x8000
  s_mov_b32 s19, 0x20000
  s_getreg_b32 s7, hwreg(HW_REG_XCC_ID, 0, 4)
  s_mov_b32 s24, 0x3e9837f0
  s_mov_b32 s25, 0x3e9837f0
  s_mov_b32 s26, 0x3fb8aa3c
  s_mov_b32 s27, 0x3fb8aa3c
  s_mov_b32 s28, 0x3eb504f3
  s_mov_b32 s29, 0x3eb504f3
  s_mov_b32 s30, 0x358637bd
  s_mov_b32 s31, 0x358637bd
  s_mov_b32 s32, 0xffff0000
  s_mov_b32 s33, 0x05040100
  s_mov_b32 s34, 0x07060302
  s_mov_b32 s50, 0xaaaaaaaa
  s_mov_b32 s51, 0xaaaaaaaa
  s_mov_b32 s36, 0x100001
  s_mov_b32 s37, 0x10000100
  s_mov_b32 s38, 0x200002
  s_mov_b32 s39, 0x20000200
  s_mov_b32 s40, 0x400004
  s_mov_b32 s41, 0x40000400
  s_mov_b32 s42, 0x800008
  s_mov_b32 s43, 0x80000800
  v_mov_b32 v32, 0x3f80
  v_mov_b32 v33, 0x3f800000
  v_cndmask_b32 v184, 0, v32, s[36:37]
  v_cndmask_b32 v184, v184, v33, s[38:39]
  v_cndmask_b32 v185, 0, v32, s[40:41]
  v_cndmask_b32 v185, v185, v33, s[42:43]
  s_waitcnt vmcnt(0) lgkmcnt(0)
  s_add_u32 s6, s6, 0x9e3779b9
  s_add_u32 s6, s6, s7
  s_lshl_b32 s62, s5, 2
  s_add_u32 s62, s62, 0x1e00
  v_mov_b32 v188, s6
  s_mov_b64 exec, 1
  buffer_store_dword v188, off, s[16:19], s62
  s_mov_b64 exec, -1
  v_perm_b32 v112, v132, v128, s33
  v_perm_b32 v113, v132, v128, s33
  v_perm_b32 v114, v132, v128, s34
  v_perm_b32 v115, v132, v128, s34
  v_perm_b32 v116, v133, v129, s33
  v_perm_b32 v117, v133, v129, s33
  v_perm_b32 v118, v133, v129, s34
  v_perm_b32 v119, v133, v129, s34
  v_perm_b32 v120, v134, v130, s33
  v_perm_b32 v121, v134, v130, s33
  v_perm_b32 v122, v134, v130, s34
  v_perm_b32 v123, v134, v130, s34
  v_perm_b32 v124, v135, v131, s33
  v_perm_b32 v125, v135, v131, s33
  v_perm_b32 v126, v135, v131, s34
  v_perm_b32 v127, v135, v131, s34
  s_nop 1
  v_mfma_f32_16x16x16_bf16 v[160:163], v[112:113], v[184:185], 0
  v_mfma_f32_16x16x16_bf16 v[164:167], v[114:115], v[184:185], 0
  v_mfma_f32_16x16x16_bf16 v[168:171], v[116:117], v[184:185], 0
  v_mfma_f32_16x16x16_bf16 v[172:175], v[118:119], v[184:185], 0
  s_nop 6
  v_cvt_pk_bf16_f32 v48, v160, v161
  v_cvt_pk_bf16_f32 v49, v162, v163
  v_cvt_pk_bf16_f32 v50, v164, v165
  v_cvt_pk_bf16_f32 v51, v166, v167
  v_cvt_pk_bf16_f32 v52, v168, v169
  v_cvt_pk_bf16_f32 v53, v170, v171
  v_cvt_pk_bf16_f32 v54, v172, v173
  v_cvt_pk_bf16_f32 v55, v174, v175
  s_nop 1
  v_mfma_f32_16x16x16_bf16 v[160:163], v[120:121], v[184:185], 0
  v_mfma_f32_16x16x16_bf16 v[164:167], v[122:123], v[184:185], 0
  v_mfma_f32_16x16x16_bf16 v[168:171], v[124:125], v[184:185], 0
  v_mfma_f32_16x16x16_bf16 v[172:175], v[126:127], v[184:185], 0
  s_nop 6
  v_cvt_pk_bf16_f32 v56, v160, v161
  v_cvt_pk_bf16_f32 v57, v162, v163
  v_cvt_pk_bf16_f32 v58, v164, v165
  v_cvt_pk_bf16_f32 v59, v166, v167
  v_cvt_pk_bf16_f32 v60, v168, v169
  v_cvt_pk_bf16_f32 v61, v170, v171
  v_cvt_pk_bf16_f32 v62, v172, v173
  v_cvt_pk_bf16_f32 v63, v174, v175
  v_perm_b32 v64, v148, v144, s33
  v_perm_b32 v65, v156, v152, s33
  v_perm_b32 v66, v148, v144, s34
  v_perm_b32 v67, v156, v152, s34
  v_perm_b32 v68, v149, v145, s33
  v_perm_b32 v69, v157, v153, s33
  v_perm_b32 v70, v149, v145, s34
  v_perm_b32 v71, v157, v153, s34
  v_perm_b32 v72, v150, v146, s33
  v_perm_b32 v73, v158, v154, s33
  v_perm_b32 v74, v150, v146, s34
  v_perm_b32 v75, v158, v154, s34
  v_perm_b32 v76, v151, v147, s33
  v_perm_b32 v77, v159, v155, s33
  v_perm_b32 v78, v151, v147, s34
  v_perm_b32 v79, v159, v155, s34
  v_lshlrev_b32 v32, 16, v64
  v_and_b32 v33, s32, v64
  v_lshlrev_b32 v34, 16, v65
  v_and_b32 v35, s32, v65
  v_lshlrev_b32 v36, 16, v66
  v_and_b32 v37, s32, v66
  v_lshlrev_b32 v38, 16, v67
  v_and_b32 v39, s32, v67
  v_pk_mul_f32 v[32:33], v[32:33], s[24:25]
  v_pk_mul_f32 v[34:35], v[34:35], s[24:25]
  v_pk_mul_f32 v[36:37], v[36:37], s[24:25]
  v_pk_mul_f32 v[38:39], v[38:39], s[24:25]
  v_cvt_pk_bf16_f32 v64, v32, v33
  v_cvt_pk_bf16_f32 v65, v34, v35
  v_cvt_pk_bf16_f32 v66, v36, v37
  v_cvt_pk_bf16_f32 v67, v38, v39
  v_lshlrev_b32 v32, 16, v68
  v_and_b32 v33, s32, v68
  v_lshlrev_b32 v34, 16, v69
  v_and_b32 v35, s32, v69
  v_lshlrev_b32 v36, 16, v70
  v_and_b32 v37, s32, v70
  v_lshlrev_b32 v38, 16, v71
  v_and_b32 v39, s32, v71
  v_pk_mul_f32 v[32:33], v[32:33], s[24:25]
  v_pk_mul_f32 v[34:35], v[34:35], s[24:25]
  v_pk_mul_f32 v[36:37], v[36:37], s[24:25]
  v_pk_mul_f32 v[38:39], v[38:39], s[24:25]
  v_cvt_pk_bf16_f32 v68, v32, v33
  v_cvt_pk_bf16_f32 v69, v34, v35
  v_cvt_pk_bf16_f32 v70, v36, v37
  v_cvt_pk_bf16_f32 v71, v38, v39
  v_lshlrev_b32 v32, 16, v72
  v_and_b32 v33, s32, v72
  v_lshlrev_b32 v34, 16, v73
  v_and_b32 v35, s32, v73
  v_lshlrev_b32 v36, 16, v74
  v_and_b32 v37, s32, v74
  v_lshlrev_b32 v38, 16, v75
  v_and_b32 v39, s32, v75
  v_pk_mul_f32 v[32:33], v[32:33], s[24:25]
  v_pk_mul_f32 v[34:35], v[34:35], s[24:25]
  v_pk_mul_f32 v[36:37], v[36:37], s[24:25]
  v_pk_mul_f32 v[38:39], v[38:39], s[24:25]
  v_cvt_pk_bf16_f32 v72, v32, v33
  v_cvt_pk_bf16_f32 v73, v34, v35
  v_cvt_pk_bf16_f32 v74, v36, v37
  v_cvt_pk_bf16_f32 v75, v38, v39
  v_lshlrev_b32 v32, 16, v76
  v_and_b32 v33, s32, v76
  v_lshlrev_b32 v34, 16, v77
  v_and_b32 v35, s32, v77
  v_lshlrev_b32 v36, 16, v78
  v_and_b32 v37, s32, v78
  v_lshlrev_b32 v38, 16, v79
  v_and_b32 v39, s32, v79
  v_pk_mul_f32 v[32:33], v[32:33], s[24:25]
  v_pk_mul_f32 v[34:35], v[34:35], s[24:25]
  v_pk_mul_f32 v[36:37], v[36:37], s[24:25]
  v_pk_mul_f32 v[38:39], v[38:39], s[24:25]
  v_cvt_pk_bf16_f32 v76, v32, v33
  v_cvt_pk_bf16_f32 v77, v34, v35
  v_cvt_pk_bf16_f32 v78, v36, v37
  v_cvt_pk_bf16_f32 v79, v38, v39
  s_nop 1
  v_mfma_f32_16x16x32_bf16 v[4:7], v[48:51], v[64:67], 0
  v_mfma_f32_16x16x32_bf16 v[8:11], v[64:67], v[64:67], 0
  v_mfma_f32_16x16x32_bf16 v[4:7], v[52:55], v[68:71], v[4:7]
  v_mfma_f32_16x16x32_bf16 v[8:11], v[68:71], v[68:71], v[8:11]
  v_mfma_f32_16x16x32_bf16 v[4:7], v[56:59], v[72:75], v[4:7]
  v_mfma_f32_16x16x32_bf16 v[8:11], v[72:75], v[72:75], v[8:11]
  v_mfma_f32_16x16x32_bf16 v[4:7], v[60:63], v[76:79], v[4:7]
  v_mfma_f32_16x16x32_bf16 v[8:11], v[76:79], v[76:79], v[8:11]
  s_nop 7
  v_cvt_pk_bf16_f32 v32, v4, v5
  v_cvt_pk_bf16_f32 v33, v6, v7
  v_lshlrev_b32 v16, 16, v32
  v_and_b32 v17, s32, v32
  v_lshlrev_b32 v18, 16, v33
  v_and_b32 v19, s32, v33
  v_cvt_pk_bf16_f32 v34, v8, v8
  v_and_b32 v34, s32, v34
  v_fma_f32 v16, v34, -0.5, v16
  v_fma_f32 v17, v34, -0.5, v17
  v_fma_f32 v18, v34, -0.5, v18
  v_fma_f32 v19, v34, -0.5, v19
  v_cvt_pk_bf16_f32 v32, v16, v17
  v_cvt_pk_bf16_f32 v33, v18, v19
  v_lshlrev_b32 v16, 16, v32
  v_and_b32 v17, s32, v32
  v_lshlrev_b32 v18, 16, v33
  v_and_b32 v19, s32, v33
  v_pk_mul_f32 v[16:17], v[16:17], s[26:27]
  v_pk_mul_f32 v[18:19], v[18:19], s[26:27]
  v_exp_f32 v16, v16
  v_exp_f32 v17, v17
  v_exp_f32 v18, v18
  v_exp_f32 v19, v19
  s_nop 0
  v_cvt_pk_bf16_f32 v32, v16, v17
  v_cvt_pk_bf16_f32 v33, v18, v19
  v_lshlrev_b32 v16, 16, v32
  v_and_b32 v17, s32, v32
  v_lshlrev_b32 v18, 16, v33
  v_and_b32 v19, s32, v33
  v_pk_mul_f32 v[16:17], v[16:17], s[28:29]
  v_pk_mul_f32 v[18:19], v[18:19], s[28:29]
  v_cvt_pk_bf16_f32 v32, v16, v17
  v_cvt_pk_bf16_f32 v33, v18, v19
  v_lshlrev_b32 v16, 16, v32
  v_and_b32 v17, s32, v32
  v_lshlrev_b32 v18, 16, v33
  v_and_b32 v19, s32, v33
  v_pk_add_f32 v[16:17], v[16:17], s[30:31]
  v_pk_add_f32 v[18:19], v[18:19], s[30:31]
  v_cvt_pk_bf16_f32 v32, v16, v17
  v_cvt_pk_bf16_f32 v33, v18, v19
  v_lshlrev_b32 v44, 16, v32
  v_and_b32 v45, s32, v32
  v_lshlrev_b32 v46, 16, v33
  v_and_b32 v47, s32, v33
  v_cndmask_b32 v46, v44, v45, s[50:51]
  ds_write_b128 v3, v[44:47] offset:20480
  s_waitcnt lgkmcnt(0)
  s_endpgm
L_codeend:
.section .rodata,"a"
.p2align 6
.amdhsa_kernel standalone__linear_kernel_rfa__decode_kernel
  .amdhsa_next_free_vgpr 224
  .amdhsa_next_free_sgpr 84
  .amdhsa_accum_offset 224
  .amdhsa_group_segment_fixed_size 0
  .amdhsa_kernarg_size 56
  .amdhsa_user_sgpr_count 2
  .amdhsa_user_sgpr_kernarg_segment_ptr 1
  .amdhsa_system_sgpr_workgroup_id_x 1
  .amdhsa_float_denorm_mode_32 3
.end_amdhsa_kernel
```
